```python
import torch

def _softmax(x, axis=-1):
    return torch.softmax(x, dim=axis)
def _gelu(x):
    return torch.nn.functional.gelu(x, approximate="tanh")
def _silu(x):
    return torch.nn.functional.silu(x)
def _sigmoid(x):
    return torch.sigmoid(x)
def _layernorm(x, axis=-1, eps=1e-5):
    m = x.mean(dim=axis, keepdim=True)
    v = x.var(dim=axis, keepdim=True, unbiased=False)
    return (x - m) / torch.sqrt(v + eps)
def _scatter_add(tgt, idx, src, axis=0):
    return tgt.clone().index_add_(axis, idx, src)
def _segment_sum(src, seg, n):
    out = torch.zeros((n,) + src.shape[1:], dtype=src.dtype)
    return out.index_add_(0, seg, src)
def _pad(x, pw):
    flat = tuple(v for pair in reversed(pw) for v in pair)
    return torch.nn.functional.pad(x, flat)

kernel_name = 'standalone__rmsnorm__sampling'

def setup_inputs():

    _w = (lambda a: (lambda t: t.to(torch.bfloat16) if t.is_floating_point() else t)(torch.as_tensor(a)))
    B, S, D = 512, 32, 640
    return {
        "x": _w((lambda *s: torch.randn(*s, dtype=torch.bfloat16) * 0.05)(B, S, D)),
        "g": _w((lambda *s: torch.randn(*s, dtype=torch.bfloat16) * 0.05)(D) + 1.0),
    }

def reference(x, g):
    rms = torch.sqrt((x * x).mean(axis=-1, keepdims=True) + 1e-6)
    return x / rms * g
```

```asm
; @launch grid=(512,1,1) block=(256,1,1) lds=0
.amdgcn_target "amdgcn-amd-amdhsa--gfx950"
.text
.globl standalone__rmsnorm__sampling_kernel
.p2align 8
.type standalone__rmsnorm__sampling_kernel,@function
standalone__rmsnorm__sampling_kernel:
    s_load_dwordx4 s[4:7], s[0:1], 0
    s_load_dwordx2 s[8:9], s[0:1], 16
    s_cmp_ge_u32 s2, 512
    s_cbranch_scc1 L_done
    v_and_b32 v2, 15, v0
    v_lshlrev_b32 v2, 4, v2
    v_lshrrev_b32 v1, 6, v0
    v_mul_u32_u24 v1, 10240, v1
    v_bfe_u32 v3, v0, 4, 2
    v_mul_u32_u24 v3, 1280, v3
    v_add_u32 v1, v1, v3
    s_mul_i32 s3, s2, 40960
    v_add3_u32 v1, v1, v2, s3
    v_add_u32 v3, 5120, v1
    s_waitcnt lgkmcnt(0)
    global_load_dwordx4 v[44:47], v2, s[6:7] offset:0
    global_load_dwordx4 v[48:51], v2, s[6:7] offset:256
    global_load_dwordx4 v[52:55], v2, s[6:7] offset:512
    global_load_dwordx4 v[56:59], v2, s[6:7] offset:768
    global_load_dwordx4 v[60:63], v2, s[6:7] offset:1024
    global_load_dwordx4 v[4:7], v1, s[4:5] offset:0
    global_load_dwordx4 v[8:11], v1, s[4:5] offset:256
    global_load_dwordx4 v[12:15], v1, s[4:5] offset:512
    global_load_dwordx4 v[16:19], v1, s[4:5] offset:768
    global_load_dwordx4 v[20:23], v1, s[4:5] offset:1024
    global_load_dwordx4 v[24:27], v3, s[4:5] offset:0
    global_load_dwordx4 v[28:31], v3, s[4:5] offset:256
    global_load_dwordx4 v[32:35], v3, s[4:5] offset:512
    global_load_dwordx4 v[36:39], v3, s[4:5] offset:768
    global_load_dwordx4 v[40:43], v3, s[4:5] offset:1024
    s_mov_b32 s10, 0x3acccccd
    s_mov_b32 s11, 0x358637bd
    s_waitcnt vmcnt(5)
    v_dot2_f32_bf16 v64, v4, v4, 0
    v_dot2_f32_bf16 v65, v5, v5, 0
    v_dot2_f32_bf16 v66, v6, v6, 0
    v_dot2_f32_bf16 v67, v7, v7, 0
    v_dot2c_f32_bf16 v64, v8, v8
    v_dot2c_f32_bf16 v65, v9, v9
    v_dot2c_f32_bf16 v66, v10, v10
    v_dot2c_f32_bf16 v67, v11, v11
    v_dot2c_f32_bf16 v64, v12, v12
    v_dot2c_f32_bf16 v65, v13, v13
    v_dot2c_f32_bf16 v66, v14, v14
    v_dot2c_f32_bf16 v67, v15, v15
    v_dot2c_f32_bf16 v64, v16, v16
    v_dot2c_f32_bf16 v65, v17, v17
    v_dot2c_f32_bf16 v66, v18, v18
    v_dot2c_f32_bf16 v67, v19, v19
    v_dot2c_f32_bf16 v64, v20, v20
    v_dot2c_f32_bf16 v65, v21, v21
    v_dot2c_f32_bf16 v66, v22, v22
    v_dot2c_f32_bf16 v67, v23, v23
    v_lshlrev_b32 v78, 16, v44
    v_and_b32 v79, 0xffff0000, v44
    v_lshlrev_b32 v80, 16, v45
    v_and_b32 v81, 0xffff0000, v45
    v_lshlrev_b32 v82, 16, v46
    v_and_b32 v83, 0xffff0000, v46
    v_lshlrev_b32 v84, 16, v47
    v_and_b32 v85, 0xffff0000, v47
    v_lshlrev_b32 v86, 16, v48
    v_and_b32 v87, 0xffff0000, v48
    v_lshlrev_b32 v88, 16, v49
    v_and_b32 v89, 0xffff0000, v49
    v_lshlrev_b32 v90, 16, v50
    v_and_b32 v91, 0xffff0000, v50
    v_lshlrev_b32 v92, 16, v51
    v_and_b32 v93, 0xffff0000, v51
    v_lshlrev_b32 v94, 16, v52
    v_and_b32 v95, 0xffff0000, v52
    v_lshlrev_b32 v96, 16, v53
    v_and_b32 v97, 0xffff0000, v53
    v_lshlrev_b32 v98, 16, v54
    v_and_b32 v99, 0xffff0000, v54
    v_lshlrev_b32 v100, 16, v55
    v_and_b32 v101, 0xffff0000, v55
    v_lshlrev_b32 v102, 16, v56
    v_and_b32 v103, 0xffff0000, v56
    v_lshlrev_b32 v104, 16, v57
    v_and_b32 v105, 0xffff0000, v57
    v_lshlrev_b32 v106, 16, v58
    v_and_b32 v107, 0xffff0000, v58
    v_lshlrev_b32 v108, 16, v59
    v_and_b32 v109, 0xffff0000, v59
    v_lshlrev_b32 v110, 16, v60
    v_and_b32 v111, 0xffff0000, v60
    v_lshlrev_b32 v112, 16, v61
    v_and_b32 v113, 0xffff0000, v61
    v_lshlrev_b32 v114, 16, v62
    v_and_b32 v115, 0xffff0000, v62
    v_lshlrev_b32 v116, 16, v63
    v_and_b32 v117, 0xffff0000, v63
    v_add_f32 v64, v64, v65
    v_add_f32 v66, v66, v67
    v_add_f32 v64, v64, v66
    s_nop 1
    v_add_f32_dpp v64, v64, v64 row_ror:8 row_mask:0xf bank_mask:0xf
    s_nop 1
    v_add_f32_dpp v64, v64, v64 row_ror:4 row_mask:0xf bank_mask:0xf
    s_nop 1
    v_add_f32_dpp v64, v64, v64 row_ror:2 row_mask:0xf bank_mask:0xf
    s_nop 1
    v_add_f32_dpp v64, v64, v64 row_ror:1 row_mask:0xf bank_mask:0xf
    v_mov_b32 v65, s11
    v_fma_f32 v64, v64, s10, v65
    v_rsq_f32 v76, v64
    s_nop 0
    v_lshlrev_b32 v68, 16, v4
    v_and_b32 v69, 0xffff0000, v4
    v_pk_mul_f32 v[68:69], v[68:69], v[76:77] op_sel_hi:[1,0]
    v_pk_mul_f32 v[68:69], v[68:69], v[78:79]
    v_cvt_pk_bf16_f32 v4, v68, v69
    v_lshlrev_b32 v72, 16, v5
    v_and_b32 v73, 0xffff0000, v5
    v_pk_mul_f32 v[72:73], v[72:73], v[76:77] op_sel_hi:[1,0]
    v_pk_mul_f32 v[72:73], v[72:73], v[80:81]
    v_cvt_pk_bf16_f32 v5, v72, v73
    v_lshlrev_b32 v68, 16, v6
    v_and_b32 v69, 0xffff0000, v6
    v_pk_mul_f32 v[68:69], v[68:69], v[76:77] op_sel_hi:[1,0]
    v_pk_mul_f32 v[68:69], v[68:69], v[82:83]
    v_cvt_pk_bf16_f32 v6, v68, v69
    v_lshlrev_b32 v72, 16, v7
    v_and_b32 v73, 0xffff0000, v7
    v_pk_mul_f32 v[72:73], v[72:73], v[76:77] op_sel_hi:[1,0]
    v_pk_mul_f32 v[72:73], v[72:73], v[84:85]
    v_cvt_pk_bf16_f32 v7, v72, v73
    global_store_dwordx4 v1, v[4:7], s[8:9] offset:0
    v_lshlrev_b32 v68, 16, v8
    v_and_b32 v69, 0xffff0000, v8
    v_pk_mul_f32 v[68:69], v[68:69], v[76:77] op_sel_hi:[1,0]
    v_pk_mul_f32 v[68:69], v[68:69], v[86:87]
    v_cvt_pk_bf16_f32 v8, v68, v69
    v_lshlrev_b32 v72, 16, v9
    v_and_b32 v73, 0xffff0000, v9
    v_pk_mul_f32 v[72:73], v[72:73], v[76:77] op_sel_hi:[1,0]
    v_pk_mul_f32 v[72:73], v[72:73], v[88:89]
    v_cvt_pk_bf16_f32 v9, v72, v73
    v_lshlrev_b32 v68, 16, v10
    v_and_b32 v69, 0xffff0000, v10
    v_pk_mul_f32 v[68:69], v[68:69], v[76:77] op_sel_hi:[1,0]
    v_pk_mul_f32 v[68:69], v[68:69], v[90:91]
    v_cvt_pk_bf16_f32 v10, v68, v69
    v_lshlrev_b32 v72, 16, v11
    v_and_b32 v73, 0xffff0000, v11
    v_pk_mul_f32 v[72:73], v[72:73], v[76:77] op_sel_hi:[1,0]
    v_pk_mul_f32 v[72:73], v[72:73], v[92:93]
    v_cvt_pk_bf16_f32 v11, v72, v73
    global_store_dwordx4 v1, v[8:11], s[8:9] offset:256
    v_lshlrev_b32 v68, 16, v12
    v_and_b32 v69, 0xffff0000, v12
    v_pk_mul_f32 v[68:69], v[68:69], v[76:77] op_sel_hi:[1,0]
    v_pk_mul_f32 v[68:69], v[68:69], v[94:95]
    v_cvt_pk_bf16_f32 v12, v68, v69
    v_lshlrev_b32 v72, 16, v13
    v_and_b32 v73, 0xffff0000, v13
    v_pk_mul_f32 v[72:73], v[72:73], v[76:77] op_sel_hi:[1,0]
    v_pk_mul_f32 v[72:73], v[72:73], v[96:97]
    v_cvt_pk_bf16_f32 v13, v72, v73
    v_lshlrev_b32 v68, 16, v14
    v_and_b32 v69, 0xffff0000, v14
    v_pk_mul_f32 v[68:69], v[68:69], v[76:77] op_sel_hi:[1,0]
    v_pk_mul_f32 v[68:69], v[68:69], v[98:99]
    v_cvt_pk_bf16_f32 v14, v68, v69
    v_lshlrev_b32 v72, 16, v15
    v_and_b32 v73, 0xffff0000, v15
    v_pk_mul_f32 v[72:73], v[72:73], v[76:77] op_sel_hi:[1,0]
    v_pk_mul_f32 v[72:73], v[72:73], v[100:101]
    v_cvt_pk_bf16_f32 v15, v72, v73
    global_store_dwordx4 v1, v[12:15], s[8:9] offset:512
    v_lshlrev_b32 v68, 16, v16
    v_and_b32 v69, 0xffff0000, v16
    v_pk_mul_f32 v[68:69], v[68:69], v[76:77] op_sel_hi:[1,0]
    v_pk_mul_f32 v[68:69], v[68:69], v[102:103]
    v_cvt_pk_bf16_f32 v16, v68, v69
    v_lshlrev_b32 v72, 16, v17
    v_and_b32 v73, 0xffff0000, v17
    v_pk_mul_f32 v[72:73], v[72:73], v[76:77] op_sel_hi:[1,0]
    v_pk_mul_f32 v[72:73], v[72:73], v[104:105]
    v_cvt_pk_bf16_f32 v17, v72, v73
    v_lshlrev_b32 v68, 16, v18
    v_and_b32 v69, 0xffff0000, v18
    v_pk_mul_f32 v[68:69], v[68:69], v[76:77] op_sel_hi:[1,0]
    v_pk_mul_f32 v[68:69], v[68:69], v[106:107]
    v_cvt_pk_bf16_f32 v18, v68, v69
    v_lshlrev_b32 v72, 16, v19
    v_and_b32 v73, 0xffff0000, v19
    v_pk_mul_f32 v[72:73], v[72:73], v[76:77] op_sel_hi:[1,0]
    v_pk_mul_f32 v[72:73], v[72:73], v[108:109]
    v_cvt_pk_bf16_f32 v19, v72, v73
    global_store_dwordx4 v1, v[16:19], s[8:9] offset:768
    v_lshlrev_b32 v68, 16, v20
    v_and_b32 v69, 0xffff0000, v20
    v_pk_mul_f32 v[68:69], v[68:69], v[76:77] op_sel_hi:[1,0]
    v_pk_mul_f32 v[68:69], v[68:69], v[110:111]
    v_cvt_pk_bf16_f32 v20, v68, v69
    v_lshlrev_b32 v72, 16, v21
    v_and_b32 v73, 0xffff0000, v21
    v_pk_mul_f32 v[72:73], v[72:73], v[76:77] op_sel_hi:[1,0]
    v_pk_mul_f32 v[72:73], v[72:73], v[112:113]
    v_cvt_pk_bf16_f32 v21, v72, v73
    v_lshlrev_b32 v68, 16, v22
    v_and_b32 v69, 0xffff0000, v22
    v_pk_mul_f32 v[68:69], v[68:69], v[76:77] op_sel_hi:[1,0]
    v_pk_mul_f32 v[68:69], v[68:69], v[114:115]
    v_cvt_pk_bf16_f32 v22, v68, v69
    v_lshlrev_b32 v72, 16, v23
    v_and_b32 v73, 0xffff0000, v23
    v_pk_mul_f32 v[72:73], v[72:73], v[76:77] op_sel_hi:[1,0]
    v_pk_mul_f32 v[72:73], v[72:73], v[116:117]
    v_cvt_pk_bf16_f32 v23, v72, v73
    global_store_dwordx4 v1, v[20:23], s[8:9] offset:1024
    s_waitcnt vmcnt(5)
    v_dot2_f32_bf16 v64, v24, v24, 0
    v_dot2_f32_bf16 v65, v25, v25, 0
    v_dot2_f32_bf16 v66, v26, v26, 0
    v_dot2_f32_bf16 v67, v27, v27, 0
    v_dot2c_f32_bf16 v64, v28, v28
    v_dot2c_f32_bf16 v65, v29, v29
    v_dot2c_f32_bf16 v66, v30, v30
    v_dot2c_f32_bf16 v67, v31, v31
    v_dot2c_f32_bf16 v64, v32, v32
    v_dot2c_f32_bf16 v65, v33, v33
    v_dot2c_f32_bf16 v66, v34, v34
    v_dot2c_f32_bf16 v67, v35, v35
    v_dot2c_f32_bf16 v64, v36, v36
    v_dot2c_f32_bf16 v65, v37, v37
    v_dot2c_f32_bf16 v66, v38, v38
    v_dot2c_f32_bf16 v67, v39, v39
    v_dot2c_f32_bf16 v64, v40, v40
    v_dot2c_f32_bf16 v65, v41, v41
    v_dot2c_f32_bf16 v66, v42, v42
    v_dot2c_f32_bf16 v67, v43, v43
    s_nop 3
    v_add_f32 v64, v64, v65
    v_add_f32 v66, v66, v67
    v_add_f32 v64, v64, v66
    s_nop 1
    v_add_f32_dpp v64, v64, v64 row_ror:8 row_mask:0xf bank_mask:0xf
    s_nop 1
    v_add_f32_dpp v64, v64, v64 row_ror:4 row_mask:0xf bank_mask:0xf
    s_nop 1
    v_add_f32_dpp v64, v64, v64 row_ror:2 row_mask:0xf bank_mask:0xf
    s_nop 1
    v_add_f32_dpp v64, v64, v64 row_ror:1 row_mask:0xf bank_mask:0xf
    v_mov_b32 v65, s11
    v_fma_f32 v64, v64, s10, v65
    v_rsq_f32 v76, v64
    s_nop 0
    v_lshlrev_b32 v68, 16, v24
    v_and_b32 v69, 0xffff0000, v24
    v_pk_mul_f32 v[68:69], v[68:69], v[76:77] op_sel_hi:[1,0]
    v_pk_mul_f32 v[68:69], v[68:69], v[78:79]
    v_cvt_pk_bf16_f32 v24, v68, v69
    v_lshlrev_b32 v72, 16, v25
    v_and_b32 v73, 0xffff0000, v25
    v_pk_mul_f32 v[72:73], v[72:73], v[76:77] op_sel_hi:[1,0]
    v_pk_mul_f32 v[72:73], v[72:73], v[80:81]
    v_cvt_pk_bf16_f32 v25, v72, v73
    v_lshlrev_b32 v68, 16, v26
    v_and_b32 v69, 0xffff0000, v26
    v_pk_mul_f32 v[68:69], v[68:69], v[76:77] op_sel_hi:[1,0]
    v_pk_mul_f32 v[68:69], v[68:69], v[82:83]
    v_cvt_pk_bf16_f32 v26, v68, v69
    v_lshlrev_b32 v72, 16, v27
    v_and_b32 v73, 0xffff0000, v27
    v_pk_mul_f32 v[72:73], v[72:73], v[76:77] op_sel_hi:[1,0]
    v_pk_mul_f32 v[72:73], v[72:73], v[84:85]
    v_cvt_pk_bf16_f32 v27, v72, v73
    global_store_dwordx4 v3, v[24:27], s[8:9] offset:0
    v_lshlrev_b32 v68, 16, v28
    v_and_b32 v69, 0xffff0000, v28
    v_pk_mul_f32 v[68:69], v[68:69], v[76:77] op_sel_hi:[1,0]
    v_pk_mul_f32 v[68:69], v[68:69], v[86:87]
    v_cvt_pk_bf16_f32 v28, v68, v69
    v_lshlrev_b32 v72, 16, v29
    v_and_b32 v73, 0xffff0000, v29
    v_pk_mul_f32 v[72:73], v[72:73], v[76:77] op_sel_hi:[1,0]
    v_pk_mul_f32 v[72:73], v[72:73], v[88:89]
    v_cvt_pk_bf16_f32 v29, v72, v73
    v_lshlrev_b32 v68, 16, v30
    v_and_b32 v69, 0xffff0000, v30
    v_pk_mul_f32 v[68:69], v[68:69], v[76:77] op_sel_hi:[1,0]
    v_pk_mul_f32 v[68:69], v[68:69], v[90:91]
    v_cvt_pk_bf16_f32 v30, v68, v69
    v_lshlrev_b32 v72, 16, v31
    v_and_b32 v73, 0xffff0000, v31
    v_pk_mul_f32 v[72:73], v[72:73], v[76:77] op_sel_hi:[1,0]
    v_pk_mul_f32 v[72:73], v[72:73], v[92:93]
    v_cvt_pk_bf16_f32 v31, v72, v73
    global_store_dwordx4 v3, v[28:31], s[8:9] offset:256
    v_lshlrev_b32 v68, 16, v32
    v_and_b32 v69, 0xffff0000, v32
    v_pk_mul_f32 v[68:69], v[68:69], v[76:77] op_sel_hi:[1,0]
    v_pk_mul_f32 v[68:69], v[68:69], v[94:95]
    v_cvt_pk_bf16_f32 v32, v68, v69
    v_lshlrev_b32 v72, 16, v33
    v_and_b32 v73, 0xffff0000, v33
    v_pk_mul_f32 v[72:73], v[72:73], v[76:77] op_sel_hi:[1,0]
    v_pk_mul_f32 v[72:73], v[72:73], v[96:97]
    v_cvt_pk_bf16_f32 v33, v72, v73
    v_lshlrev_b32 v68, 16, v34
    v_and_b32 v69, 0xffff0000, v34
    v_pk_mul_f32 v[68:69], v[68:69], v[76:77] op_sel_hi:[1,0]
    v_pk_mul_f32 v[68:69], v[68:69], v[98:99]
    v_cvt_pk_bf16_f32 v34, v68, v69
    v_lshlrev_b32 v72, 16, v35
    v_and_b32 v73, 0xffff0000, v35
    v_pk_mul_f32 v[72:73], v[72:73], v[76:77] op_sel_hi:[1,0]
    v_pk_mul_f32 v[72:73], v[72:73], v[100:101]
    v_cvt_pk_bf16_f32 v35, v72, v73
    global_store_dwordx4 v3, v[32:35], s[8:9] offset:512
    v_lshlrev_b32 v68, 16, v36
    v_and_b32 v69, 0xffff0000, v36
    v_pk_mul_f32 v[68:69], v[68:69], v[76:77] op_sel_hi:[1,0]
    v_pk_mul_f32 v[68:69], v[68:69], v[102:103]
    v_cvt_pk_bf16_f32 v36, v68, v69
    v_lshlrev_b32 v72, 16, v37
    v_and_b32 v73, 0xffff0000, v37
    v_pk_mul_f32 v[72:73], v[72:73], v[76:77] op_sel_hi:[1,0]
    v_pk_mul_f32 v[72:73], v[72:73], v[104:105]
    v_cvt_pk_bf16_f32 v37, v72, v73
    v_lshlrev_b32 v68, 16, v38
    v_and_b32 v69, 0xffff0000, v38
    v_pk_mul_f32 v[68:69], v[68:69], v[76:77] op_sel_hi:[1,0]
    v_pk_mul_f32 v[68:69], v[68:69], v[106:107]
    v_cvt_pk_bf16_f32 v38, v68, v69
    v_lshlrev_b32 v72, 16, v39
    v_and_b32 v73, 0xffff0000, v39
    v_pk_mul_f32 v[72:73], v[72:73], v[76:77] op_sel_hi:[1,0]
    v_pk_mul_f32 v[72:73], v[72:73], v[108:109]
    v_cvt_pk_bf16_f32 v39, v72, v73
    global_store_dwordx4 v3, v[36:39], s[8:9] offset:768
    v_lshlrev_b32 v68, 16, v40
    v_and_b32 v69, 0xffff0000, v40
    v_pk_mul_f32 v[68:69], v[68:69], v[76:77] op_sel_hi:[1,0]
    v_pk_mul_f32 v[68:69], v[68:69], v[110:111]
    v_cvt_pk_bf16_f32 v40, v68, v69
    v_lshlrev_b32 v72, 16, v41
    v_and_b32 v73, 0xffff0000, v41
    v_pk_mul_f32 v[72:73], v[72:73], v[76:77] op_sel_hi:[1,0]
    v_pk_mul_f32 v[72:73], v[72:73], v[112:113]
    v_cvt_pk_bf16_f32 v41, v72, v73
    v_lshlrev_b32 v68, 16, v42
    v_and_b32 v69, 0xffff0000, v42
    v_pk_mul_f32 v[68:69], v[68:69], v[76:77] op_sel_hi:[1,0]
    v_pk_mul_f32 v[68:69], v[68:69], v[114:115]
    v_cvt_pk_bf16_f32 v42, v68, v69
    v_lshlrev_b32 v72, 16, v43
    v_and_b32 v73, 0xffff0000, v43
    v_pk_mul_f32 v[72:73], v[72:73], v[76:77] op_sel_hi:[1,0]
    v_pk_mul_f32 v[72:73], v[72:73], v[116:117]
    v_cvt_pk_bf16_f32 v43, v72, v73
    global_store_dwordx4 v3, v[40:43], s[8:9] offset:1024
L_done:
    s_endpgm
.section .rodata,"a"
.p2align 6
.amdhsa_kernel standalone__rmsnorm__sampling_kernel
  .amdhsa_next_free_vgpr 120
  .amdhsa_next_free_sgpr 24
  .amdhsa_accum_offset 120
  .amdhsa_group_segment_fixed_size 0
  .amdhsa_kernarg_size 40
  .amdhsa_user_sgpr_count 2
  .amdhsa_user_sgpr_kernarg_segment_ptr 1
  .amdhsa_system_sgpr_workgroup_id_x 1
.end_amdhsa_kernel
```
